```python
import torch

def _softmax(x, axis=-1):
    return torch.softmax(x, dim=axis)
def _gelu(x):
    return torch.nn.functional.gelu(x, approximate="tanh")
def _silu(x):
    return torch.nn.functional.silu(x)
def _sigmoid(x):
    return torch.sigmoid(x)
def _layernorm(x, axis=-1, eps=1e-5):
    m = x.mean(dim=axis, keepdim=True)
    v = x.var(dim=axis, keepdim=True, unbiased=False)
    return (x - m) / torch.sqrt(v + eps)
def _scatter_add(tgt, idx, src, axis=0):
    return tgt.clone().index_add_(axis, idx, src)
def _segment_sum(src, seg, n):
    out = torch.zeros((n,) + src.shape[1:], dtype=src.dtype)
    return out.index_add_(0, seg, src)
def _pad(x, pw):
    flat = tuple(v for pair in reversed(pw) for v in pair)
    return torch.nn.functional.pad(x, flat)

kernel_name = 'standalone__glu_gated_geglu__decode'

def setup_inputs():

    _w = (lambda a: (lambda t: t.to(torch.bfloat16) if t.is_floating_point() else t)(torch.as_tensor(a)))
    B, S, Dm, Df = 1, 1, 1024, 3584
    return {
        "x": _w((lambda *s: torch.randn(*s, dtype=torch.bfloat16) * 0.05)(B, S, Dm)),
        "w_gate": _w((lambda *s: torch.randn(*s, dtype=torch.bfloat16) * 0.05)(Dm, Df) * (Dm ** -0.5)),
        "w_up": _w((lambda *s: torch.randn(*s, dtype=torch.bfloat16) * 0.05)(Dm, Df) * (Dm ** -0.5)),
        "w_down": _w((lambda *s: torch.randn(*s, dtype=torch.bfloat16) * 0.05)(Df, Dm) * (Df ** -0.5)),
    }

def reference(x, w_gate, w_up, w_down):
    g = torch.einsum("bsd,df->bsf", x, w_gate)
    u = torch.einsum("bsd,df->bsf", x, w_up)
    h = _gelu(g) * u
    return torch.einsum("bsf,fd->bsd", h, w_down)
```

```asm
; @launch grid=(224,1,1) block=(384,1,1) lds=256
.amdgcn_target "amdgcn-amd-amdhsa--gfx950"
.text
.globl standalone__glu_gated_geglu__decode_kernel
.p2align 8
.type standalone__glu_gated_geglu__decode_kernel,@function
standalone__glu_gated_geglu__decode_kernel:
  s_cmp_ge_u32 s2, 224
  s_cbranch_scc1 L_end
  s_load_dwordx2 s[8:9], s[0:1], 8
  s_load_dwordx2 s[12:13], s[0:1], 16
  s_load_dwordx2 s[4:5], s[0:1], 0
  s_load_dwordx2 s[16:17], s[0:1], 24
  s_load_dwordx2 s[28:29], s[0:1], 48
  s_load_dwordx2 s[20:21], s[0:1], 32
  s_mov_b32 s6, 2048
  s_mov_b32 s7, 0x00020000
  s_mov_b32 s10, 7340032
  s_mov_b32 s11, 0x00020000
  s_mov_b32 s14, 7340032
  s_mov_b32 s15, 0x00020000
  s_mov_b32 s18, 7340032
  s_mov_b32 s19, 0x00020000
  s_mov_b32 s22, 2048
  s_mov_b32 s23, 0x00020000
  s_mov_b32 s30, 696320
  s_mov_b32 s31, 0x00020000
  v_readfirstlane_b32 s32, v0
  v_and_b32 v1, 63, v0
  s_and_b32 s34, s2, 7
  s_lshr_b32 s33, s2, 3
  s_lshr_b32 s32, s32, 6
  s_lshl_b32 s57, s33, 7
  s_lshl_b32 s58, s34, 7
  s_add_u32 s58, s58, 3584
  s_cmp_ge_u32 s32, 2
  s_cbranch_scc1 L_p2
  s_lshr_b32 s38, s34, 1
  s_and_b32 s39, s34, 1
  s_mul_i32 s37, s38, 1835008
  s_lshl_b32 s43, s33, 8
  s_add_u32 s37, s37, s43
  s_lshl_b32 s43, s32, 7
  s_add_u32 s37, s37, s43
  v_lshrrev_b32 v3, 3, v1
  v_and_b32 v4, 7, v1
  v_mul_u32_u24 v2, 229376, v3
  v_lshl_add_u32 v2, v4, 4, v2
  v_lshlrev_b32 v3, 6, v3
  s_lshl_b32 s43, s38, 9
  s_cmp_lg_u32 s39, 0
  s_waitcnt lgkmcnt(0)
  s_cselect_b32 s8, s12, s8
  s_cselect_b32 s9, s13, s9
  buffer_load_dwordx4 v[40:43], v3, s[4:7], s43 offen offset:0
  buffer_load_dwordx4 v[44:47], v3, s[4:7], s43 offen offset:16
  buffer_load_dwordx4 v[48:51], v3, s[4:7], s43 offen offset:32
  buffer_load_dwordx4 v[52:55], v3, s[4:7], s43 offen offset:48
  buffer_load_dwordx4 v[56:59], v2, s[8:11], s37 offen
  s_add_u32 s37, s37, 7168
  buffer_load_dwordx4 v[60:63], v2, s[8:11], s37 offen
  s_add_u32 s37, s37, 7168
  s_load_dword s40, s[28:29], s57
  s_load_dword s56, s[28:29], s58
  buffer_load_dwordx4 v[64:67], v2, s[8:11], s37 offen
  s_add_u32 s37, s37, 7168
  buffer_load_dwordx4 v[68:71], v2, s[8:11], s37 offen
  s_add_u32 s37, s37, 7168
  buffer_load_dwordx4 v[72:75], v2, s[8:11], s37 offen
  s_add_u32 s37, s37, 7168
  buffer_load_dwordx4 v[76:79], v2, s[8:11], s37 offen
  s_add_u32 s37, s37, 7168
  buffer_load_dwordx4 v[80:83], v2, s[8:11], s37 offen
  s_add_u32 s37, s37, 7168
  buffer_load_dwordx4 v[84:87], v2, s[8:11], s37 offen
  s_add_u32 s37, s37, 7168
  buffer_load_dwordx4 v[88:91], v2, s[8:11], s37 offen
  s_add_u32 s37, s37, 7168
  buffer_load_dwordx4 v[92:95], v2, s[8:11], s37 offen
  s_add_u32 s37, s37, 7168
  buffer_load_dwordx4 v[96:99], v2, s[8:11], s37 offen
  s_add_u32 s37, s37, 7168
  buffer_load_dwordx4 v[100:103], v2, s[8:11], s37 offen
  s_add_u32 s37, s37, 7168
  buffer_load_dwordx4 v[104:107], v2, s[8:11], s37 offen
  s_add_u32 s37, s37, 7168
  buffer_load_dwordx4 v[108:111], v2, s[8:11], s37 offen
  s_add_u32 s37, s37, 7168
  buffer_load_dwordx4 v[112:115], v2, s[8:11], s37 offen
  s_add_u32 s37, s37, 7168
  buffer_load_dwordx4 v[116:119], v2, s[8:11], s37 offen
  s_add_u32 s37, s37, 7168
  s_waitcnt lgkmcnt(0)
  s_mov_b32 s41, 0x05040100
  s_mov_b32 s42, 0x07060302
  v_bfe_u32 v6, v1, 4, 1
  v_lshrrev_b32 v7, 5, v1
  v_mov_b32 v16, 0
  v_mov_b32 v17, 0
  v_mov_b32 v18, 0
  v_mov_b32 v19, 0
  v_mov_b32 v20, 0
  v_mov_b32 v21, 0
  v_mov_b32 v22, 0
  v_mov_b32 v23, 0
  v_lshlrev_b32 v4, 6, v4
  v_lshl_add_u32 v4, v7, 5, v4
  v_lshl_add_u32 v4, v6, 4, v4
  s_lshl_b32 s44, s33, 13
  s_add_u32 s44, s44, 466944
  s_lshl_b32 s45, s39, 2
  s_add_u32 s45, s45, s38
  s_lshl_b32 s45, s45, 10
  s_add_u32 s45, s45, s44
  s_lshl_b32 s46, s32, 9
  s_add_u32 s45, s45, s46
  s_mul_i32 s50, s32, 28
  s_add_u32 s50, s50, s33
  s_mul_i32 s49, s34, 28672
  s_lshl_b32 s51, s50, 5
  s_add_u32 s49, s49, s51
  s_add_u32 s49, s49, 8192
  v_lshrrev_b32 v13, 1, v1
  v_and_b32 v14, 1, v1
  v_lshlrev_b32 v13, 10, v13
  v_lshl_add_u32 v13, v14, 4, v13
  v_lshl_add_u32 v14, v14, 1, v7
  v_lshlrev_b32 v14, 1, v14
  s_lshl_b32 s48, s34, 8
  s_lshl_b32 s51, s50, 3
  s_add_u32 s48, s48, s51
  v_mov_b32 v8, 0
  v_mov_b32 v9, 0
  s_add_u32 s40, s40, 1
  s_add_u32 s56, s56, 1
  v_mov_b32 v25, s40
  v_mov_b32 v27, s40
  s_mov_b32 s62, 0x00ff00ff
  s_mov_b32 s63, 0x00ff00ff
  s_waitcnt vmcnt(14)
  v_perm_b32 v32, v60, v56, s41
  v_perm_b32 v33, v60, v56, s42
  v_perm_b32 v34, v61, v57, s41
  v_perm_b32 v35, v61, v57, s42
  v_perm_b32 v36, v62, v58, s41
  v_perm_b32 v37, v62, v58, s42
  v_perm_b32 v38, v63, v59, s41
  v_perm_b32 v39, v63, v59, s42
  buffer_load_dwordx4 v[56:59], v2, s[8:11], s37 offen
  s_add_u32 s37, s37, 7168
  buffer_load_dwordx4 v[60:63], v2, s[8:11], s37 offen
  s_add_u32 s37, s37, 7168
  v_dot2c_f32_bf16 v16, v32, v40
  v_dot2c_f32_bf16 v17, v33, v40
  v_dot2c_f32_bf16 v18, v34, v40
  v_dot2c_f32_bf16 v19, v35, v40
  v_dot2c_f32_bf16 v20, v36, v40
  v_dot2c_f32_bf16 v21, v37, v40
  v_dot2c_f32_bf16 v22, v38, v40
  v_dot2c_f32_bf16 v23, v39, v40
  s_waitcnt vmcnt(14)
  v_perm_b32 v32, v68, v64, s41
  v_perm_b32 v33, v68, v64, s42
  v_perm_b32 v34, v69, v65, s41
  v_perm_b32 v35, v69, v65, s42
  v_perm_b32 v36, v70, v66, s41
  v_perm_b32 v37, v70, v66, s42
  v_perm_b32 v38, v71, v67, s41
  v_perm_b32 v39, v71, v67, s42
  buffer_load_dwordx4 v[64:67], v2, s[8:11], s37 offen
  s_add_u32 s37, s37, 7168
  buffer_load_dwordx4 v[68:71], v2, s[8:11], s37 offen
  s_add_u32 s37, s37, 7168
  v_dot2c_f32_bf16 v16, v32, v41
  v_dot2c_f32_bf16 v17, v33, v41
  v_dot2c_f32_bf16 v18, v34, v41
  v_dot2c_f32_bf16 v19, v35, v41
  v_dot2c_f32_bf16 v20, v36, v41
  v_dot2c_f32_bf16 v21, v37, v41
  v_dot2c_f32_bf16 v22, v38, v41
  v_dot2c_f32_bf16 v23, v39, v41
  s_waitcnt vmcnt(14)
  v_perm_b32 v32, v76, v72, s41
  v_perm_b32 v33, v76, v72, s42
  v_perm_b32 v34, v77, v73, s41
  v_perm_b32 v35, v77, v73, s42
  v_perm_b32 v36, v78, v74, s41
  v_perm_b32 v37, v78, v74, s42
  v_perm_b32 v38, v79, v75, s41
  v_perm_b32 v39, v79, v75, s42
  buffer_load_dwordx4 v[72:75], v2, s[8:11], s37 offen
  s_add_u32 s37, s37, 7168
  buffer_load_dwordx4 v[76:79], v2, s[8:11], s37 offen
  s_add_u32 s37, s37, 7168
  v_dot2c_f32_bf16 v16, v32, v42
  v_dot2c_f32_bf16 v17, v33, v42
  v_dot2c_f32_bf16 v18, v34, v42
  v_dot2c_f32_bf16 v19, v35, v42
  v_dot2c_f32_bf16 v20, v36, v42
  v_dot2c_f32_bf16 v21, v37, v42
  v_dot2c_f32_bf16 v22, v38, v42
  v_dot2c_f32_bf16 v23, v39, v42
  s_waitcnt vmcnt(14)
  v_perm_b32 v32, v84, v80, s41
  v_perm_b32 v33, v84, v80, s42
  v_perm_b32 v34, v85, v81, s41
  v_perm_b32 v35, v85, v81, s42
  v_perm_b32 v36, v86, v82, s41
  v_perm_b32 v37, v86, v82, s42
  v_perm_b32 v38, v87, v83, s41
  v_perm_b32 v39, v87, v83, s42
  buffer_load_dwordx4 v[80:83], v2, s[8:11], s37 offen
  s_add_u32 s37, s37, 7168
  buffer_load_dwordx4 v[84:87], v2, s[8:11], s37 offen
  s_add_u32 s37, s37, 7168
  v_dot2c_f32_bf16 v16, v32, v43
  v_dot2c_f32_bf16 v17, v33, v43
  v_dot2c_f32_bf16 v18, v34, v43
  v_dot2c_f32_bf16 v19, v35, v43
  v_dot2c_f32_bf16 v20, v36, v43
  v_dot2c_f32_bf16 v21, v37, v43
  v_dot2c_f32_bf16 v22, v38, v43
  v_dot2c_f32_bf16 v23, v39, v43
  s_waitcnt vmcnt(14)
  v_perm_b32 v32, v92, v88, s41
  v_perm_b32 v33, v92, v88, s42
  v_perm_b32 v34, v93, v89, s41
  v_perm_b32 v35, v93, v89, s42
  v_perm_b32 v36, v94, v90, s41
  v_perm_b32 v37, v94, v90, s42
  v_perm_b32 v38, v95, v91, s41
  v_perm_b32 v39, v95, v91, s42
  buffer_load_dwordx4 v[88:91], v2, s[8:11], s37 offen
  s_add_u32 s37, s37, 7168
  buffer_load_dwordx4 v[92:95], v2, s[8:11], s37 offen
  s_add_u32 s37, s37, 7168
  v_dot2c_f32_bf16 v16, v32, v44
  v_dot2c_f32_bf16 v17, v33, v44
  v_dot2c_f32_bf16 v18, v34, v44
  v_dot2c_f32_bf16 v19, v35, v44
  v_dot2c_f32_bf16 v20, v36, v44
  v_dot2c_f32_bf16 v21, v37, v44
  v_dot2c_f32_bf16 v22, v38, v44
  v_dot2c_f32_bf16 v23, v39, v44
  s_waitcnt vmcnt(14)
  v_perm_b32 v32, v100, v96, s41
  v_perm_b32 v33, v100, v96, s42
  v_perm_b32 v34, v101, v97, s41
  v_perm_b32 v35, v101, v97, s42
  v_perm_b32 v36, v102, v98, s41
  v_perm_b32 v37, v102, v98, s42
  v_perm_b32 v38, v103, v99, s41
  v_perm_b32 v39, v103, v99, s42
  buffer_load_dwordx4 v[96:99], v2, s[8:11], s37 offen
  s_add_u32 s37, s37, 7168
  buffer_load_dwordx4 v[100:103], v2, s[8:11], s37 offen
  s_add_u32 s37, s37, 7168
  v_dot2c_f32_bf16 v16, v32, v45
  v_dot2c_f32_bf16 v17, v33, v45
  v_dot2c_f32_bf16 v18, v34, v45
  v_dot2c_f32_bf16 v19, v35, v45
  v_dot2c_f32_bf16 v20, v36, v45
  v_dot2c_f32_bf16 v21, v37, v45
  v_dot2c_f32_bf16 v22, v38, v45
  v_dot2c_f32_bf16 v23, v39, v45
  s_waitcnt vmcnt(14)
  v_perm_b32 v32, v108, v104, s41
  v_perm_b32 v33, v108, v104, s42
  v_perm_b32 v34, v109, v105, s41
  v_perm_b32 v35, v109, v105, s42
  v_perm_b32 v36, v110, v106, s41
  v_perm_b32 v37, v110, v106, s42
  v_perm_b32 v38, v111, v107, s41
  v_perm_b32 v39, v111, v107, s42
  buffer_load_dwordx4 v[104:107], v2, s[8:11], s37 offen
  s_add_u32 s37, s37, 7168
  buffer_load_dwordx4 v[108:111], v2, s[8:11], s37 offen
  s_add_u32 s37, s37, 7168
  v_dot2c_f32_bf16 v16, v32, v46
  v_dot2c_f32_bf16 v17, v33, v46
  v_dot2c_f32_bf16 v18, v34, v46
  v_dot2c_f32_bf16 v19, v35, v46
  v_dot2c_f32_bf16 v20, v36, v46
  v_dot2c_f32_bf16 v21, v37, v46
  v_dot2c_f32_bf16 v22, v38, v46
  v_dot2c_f32_bf16 v23, v39, v46
  s_waitcnt vmcnt(14)
  v_perm_b32 v32, v116, v112, s41
  v_perm_b32 v33, v116, v112, s42
  v_perm_b32 v34, v117, v113, s41
  v_perm_b32 v35, v117, v113, s42
  v_perm_b32 v36, v118, v114, s41
  v_perm_b32 v37, v118, v114, s42
  v_perm_b32 v38, v119, v115, s41
  v_perm_b32 v39, v119, v115, s42
  buffer_load_dwordx4 v[112:115], v2, s[8:11], s37 offen
  s_add_u32 s37, s37, 7168
  buffer_load_dwordx4 v[116:119], v2, s[8:11], s37 offen
  s_waitcnt lgkmcnt(0)
  s_barrier
  v_dot2c_f32_bf16 v16, v32, v47
  v_dot2c_f32_bf16 v17, v33, v47
  v_dot2c_f32_bf16 v18, v34, v47
  v_dot2c_f32_bf16 v19, v35, v47
  v_dot2c_f32_bf16 v20, v36, v47
  v_dot2c_f32_bf16 v21, v37, v47
  v_dot2c_f32_bf16 v22, v38, v47
  v_dot2c_f32_bf16 v23, v39, v47
  s_waitcnt vmcnt(14)
  v_perm_b32 v32, v60, v56, s41
  v_perm_b32 v33, v60, v56, s42
  v_perm_b32 v34, v61, v57, s41
  v_perm_b32 v35, v61, v57, s42
  v_perm_b32 v36, v62, v58, s41
  v_perm_b32 v37, v62, v58, s42
  v_perm_b32 v38, v63, v59, s41
  v_perm_b32 v39, v63, v59, s42
  v_dot2c_f32_bf16 v16, v32, v48
  v_dot2c_f32_bf16 v17, v33, v48
  v_dot2c_f32_bf16 v18, v34, v48
  v_dot2c_f32_bf16 v19, v35, v48
  v_dot2c_f32_bf16 v20, v36, v48
  v_dot2c_f32_bf16 v21, v37, v48
  v_dot2c_f32_bf16 v22, v38, v48
  v_dot2c_f32_bf16 v23, v39, v48
  s_waitcnt vmcnt(12)
  v_perm_b32 v32, v68, v64, s41
  v_perm_b32 v33, v68, v64, s42
  v_perm_b32 v34, v69, v65, s41
  v_perm_b32 v35, v69, v65, s42
  v_perm_b32 v36, v70, v66, s41
  v_perm_b32 v37, v70, v66, s42
  v_perm_b32 v38, v71, v67, s41
  v_perm_b32 v39, v71, v67, s42
  v_dot2c_f32_bf16 v16, v32, v49
  v_dot2c_f32_bf16 v17, v33, v49
  v_dot2c_f32_bf16 v18, v34, v49
  v_dot2c_f32_bf16 v19, v35, v49
  v_dot2c_f32_bf16 v20, v36, v49
  v_dot2c_f32_bf16 v21, v37, v49
  v_dot2c_f32_bf16 v22, v38, v49
  v_dot2c_f32_bf16 v23, v39, v49
  s_waitcnt vmcnt(10)
  v_perm_b32 v32, v76, v72, s41
  v_perm_b32 v33, v76, v72, s42
  v_perm_b32 v34, v77, v73, s41
  v_perm_b32 v35, v77, v73, s42
  v_perm_b32 v36, v78, v74, s41
  v_perm_b32 v37, v78, v74, s42
  v_perm_b32 v38, v79, v75, s41
  v_perm_b32 v39, v79, v75, s42
  v_dot2c_f32_bf16 v16, v32, v50
  v_dot2c_f32_bf16 v17, v33, v50
  v_dot2c_f32_bf16 v18, v34, v50
  v_dot2c_f32_bf16 v19, v35, v50
  v_dot2c_f32_bf16 v20, v36, v50
  v_dot2c_f32_bf16 v21, v37, v50
  v_dot2c_f32_bf16 v22, v38, v50
  v_dot2c_f32_bf16 v23, v39, v50
  s_waitcnt vmcnt(8)
  v_perm_b32 v32, v84, v80, s41
  v_perm_b32 v33, v84, v80, s42
  v_perm_b32 v34, v85, v81, s41
  v_perm_b32 v35, v85, v81, s42
  v_perm_b32 v36, v86, v82, s41
  v_perm_b32 v37, v86, v82, s42
  v_perm_b32 v38, v87, v83, s41
  v_perm_b32 v39, v87, v83, s42
  v_dot2c_f32_bf16 v16, v32, v51
  v_dot2c_f32_bf16 v17, v33, v51
  v_dot2c_f32_bf16 v18, v34, v51
  v_dot2c_f32_bf16 v19, v35, v51
  v_dot2c_f32_bf16 v20, v36, v51
  v_dot2c_f32_bf16 v21, v37, v51
  v_dot2c_f32_bf16 v22, v38, v51
  v_dot2c_f32_bf16 v23, v39, v51
  s_waitcnt vmcnt(6)
  v_perm_b32 v32, v92, v88, s41
  v_perm_b32 v33, v92, v88, s42
  v_perm_b32 v34, v93, v89, s41
  v_perm_b32 v35, v93, v89, s42
  v_perm_b32 v36, v94, v90, s41
  v_perm_b32 v37, v94, v90, s42
  v_perm_b32 v38, v95, v91, s41
  v_perm_b32 v39, v95, v91, s42
  v_dot2c_f32_bf16 v16, v32, v52
  v_dot2c_f32_bf16 v17, v33, v52
  v_dot2c_f32_bf16 v18, v34, v52
  v_dot2c_f32_bf16 v19, v35, v52
  v_dot2c_f32_bf16 v20, v36, v52
  v_dot2c_f32_bf16 v21, v37, v52
  v_dot2c_f32_bf16 v22, v38, v52
  v_dot2c_f32_bf16 v23, v39, v52
  s_waitcnt vmcnt(4)
  v_perm_b32 v32, v100, v96, s41
  v_perm_b32 v33, v100, v96, s42
  v_perm_b32 v34, v101, v97, s41
  v_perm_b32 v35, v101, v97, s42
  v_perm_b32 v36, v102, v98, s41
  v_perm_b32 v37, v102, v98, s42
  v_perm_b32 v38, v103, v99, s41
  v_perm_b32 v39, v103, v99, s42
  v_dot2c_f32_bf16 v16, v32, v53
  v_dot2c_f32_bf16 v17, v33, v53
  v_dot2c_f32_bf16 v18, v34, v53
  v_dot2c_f32_bf16 v19, v35, v53
  v_dot2c_f32_bf16 v20, v36, v53
  v_dot2c_f32_bf16 v21, v37, v53
  v_dot2c_f32_bf16 v22, v38, v53
  v_dot2c_f32_bf16 v23, v39, v53
  s_waitcnt vmcnt(2)
  v_perm_b32 v32, v108, v104, s41
  v_perm_b32 v33, v108, v104, s42
  v_perm_b32 v34, v109, v105, s41
  v_perm_b32 v35, v109, v105, s42
  v_perm_b32 v36, v110, v106, s41
  v_perm_b32 v37, v110, v106, s42
  v_perm_b32 v38, v111, v107, s41
  v_perm_b32 v39, v111, v107, s42
  v_dot2c_f32_bf16 v16, v32, v54
  v_dot2c_f32_bf16 v17, v33, v54
  v_dot2c_f32_bf16 v18, v34, v54
  v_dot2c_f32_bf16 v19, v35, v54
  v_dot2c_f32_bf16 v20, v36, v54
  v_dot2c_f32_bf16 v21, v37, v54
  v_dot2c_f32_bf16 v22, v38, v54
  v_dot2c_f32_bf16 v23, v39, v54
  s_waitcnt vmcnt(0)
  v_perm_b32 v32, v116, v112, s41
  v_perm_b32 v33, v116, v112, s42
  v_perm_b32 v34, v117, v113, s41
  v_perm_b32 v35, v117, v113, s42
  v_perm_b32 v36, v118, v114, s41
  v_perm_b32 v37, v118, v114, s42
  v_perm_b32 v38, v119, v115, s41
  v_perm_b32 v39, v119, v115, s42
  v_dot2c_f32_bf16 v16, v32, v55
  v_dot2c_f32_bf16 v17, v33, v55
  v_dot2c_f32_bf16 v18, v34, v55
  v_dot2c_f32_bf16 v19, v35, v55
  v_dot2c_f32_bf16 v20, v36, v55
  v_dot2c_f32_bf16 v21, v37, v55
  v_dot2c_f32_bf16 v22, v38, v55
  v_dot2c_f32_bf16 v23, v39, v55
  s_nop 0
  v_permlane32_swap_b32 v16, v20
  v_permlane32_swap_b32 v17, v21
  v_permlane32_swap_b32 v18, v22
  v_permlane32_swap_b32 v19, v23
  v_add_f32 v16, v16, v20
  v_add_f32 v17, v17, v21
  v_add_f32 v18, v18, v22
  v_add_f32 v19, v19, v23
  s_nop 0
  v_permlane16_swap_b32 v16, v18
  v_permlane16_swap_b32 v17, v19
  v_add_f32 v16, v16, v18
  v_add_f32 v17, v17, v19
  s_nop 0
  v_add_f32_dpp v24, v16, v16 row_ror:8 row_mask:0xf bank_mask:0xf
  v_add_f32_dpp v26, v17, v17 row_ror:8 row_mask:0xf bank_mask:0xf
  s_mov_b64 exec, s[62:63]
  buffer_store_dwordx4 v[24:27], v4, s[28:31], s45 offen sc1
  s_mov_b64 exec, -1
  s_barrier
  s_barrier
  s_cmp_ge_u32 s50, 32
  s_cbranch_scc1 L_fin
  s_mov_b32 s59, 0
  s_mov_b32 exec_hi, 0x00ffffff
L_poll2:
  buffer_load_dwordx4 v[64:67], v13, s[28:31], s49 offen sc1
  s_waitcnt vmcnt(0)
  v_cmp_ne_u32 vcc, s56, v65
  v_cmp_ne_u32 s[60:61], s56, v67
  v_mov_b32 v8, v64
  v_mov_b32 v9, v66
  s_or_b64 exec, s[60:61], vcc
  s_cbranch_scc0 L_got2
  s_add_u32 s59, s59, 1
  s_cmp_eq_u32 s59, 80
  s_cselect_b32 s51, 229376, 0
  s_add_u32 s49, s49, s51
  s_cmp_lt_u32 s59, 0x400000
  s_cbranch_scc1 L_poll2
L_got2:
  s_mov_b64 exec, -1
  v_permlane32_swap_b32 v8, v9
  v_add_f32 v8, v8, v9
  v_mov_b32 v9, v8
  s_nop 1
  v_permlane16_swap_b32 v8, v9
  v_add_f32 v8, v8, v9
  s_nop 1
  v_add_f32_dpp v8, v8, v8 row_ror:8 row_mask:0xf bank_mask:0xf
  s_nop 1
  v_add_f32_dpp v8, v8, v8 row_ror:4 row_mask:0xf bank_mask:0xf
  s_nop 1
  v_add_f32_dpp v8, v8, v8 row_ror:2 row_mask:0xf bank_mask:0xf
  s_mov_b32 exec_lo, 3
  s_mov_b32 exec_hi, 3
  v_cvt_pk_bf16_f32 v15, v8, v8
  buffer_store_short v15, v14, s[20:23], s48 offen
  s_cmp_lg_u32 s50, 0
  s_cbranch_scc1 L_fin
  s_mov_b64 exec, 1
  v_mov_b32 v14, 0
  v_mov_b32 v15, s56
  buffer_store_dword v15, v14, s[28:31], s58 offen
  s_branch L_fin
L_p2:
  s_sub_u32 s36, s32, 2
  s_getpc_b64 s[60:61]
L_pc:
  s_sub_u32 s60, s60, L_pc-standalone__glu_gated_geglu__decode_kernel
  s_subb_u32 s61, s61, 0
  v_lshlrev_b32 v2, 7, v1
  v_min_u32 v2, L_end-standalone__glu_gated_geglu__decode_kernel, v2
  s_cmp_lg_u32 s36, 0
  s_cbranch_scc1 L_nopf
  global_load_dword v47, v2, s[60:61]
L_nopf:
  s_mul_i32 s37, s33, 262144
  s_lshl_b32 s38, s34, 8
  s_add_u32 s37, s37, s38
  s_lshl_b32 s38, s36, 6
  s_add_u32 s37, s37, s38
  v_lshrrev_b32 v3, 2, v1
  v_and_b32 v4, 3, v1
  v_lshlrev_b32 v2, 14, v3
  v_lshl_add_u32 v2, v4, 4, v2
  v_lshlrev_b32 v3, 4, v3
  s_mov_b32 s41, 0x05040100
  s_mov_b32 s42, 0x07060302
  v_bfe_u32 v6, v1, 4, 1
  v_lshrrev_b32 v7, 5, v1
  v_mov_b32 v16, 0
  v_mov_b32 v17, 0
  v_mov_b32 v18, 0
  v_mov_b32 v19, 0
  v_mov_b32 v20, 0
  v_mov_b32 v21, 0
  v_mov_b32 v22, 0
  v_mov_b32 v23, 0
  v_lshlrev_b32 v4, 6, v4
  v_lshl_add_u32 v4, v7, 5, v4
  v_lshl_add_u32 v4, v6, 4, v4
  s_lshl_b32 s44, s33, 13
  s_add_u32 s44, s44, 466944
  s_mul_i32 s52, s34, 28
  s_add_u32 s52, s52, s33
  s_lshl_b32 s52, s52, 10
  s_lshl_b32 s46, s36, 8
  s_add_u32 s52, s52, s46
  s_add_u32 s53, s52, 237568
  s_add_u32 s52, s52, 8192
  s_add_u32 s46, s46, s44
  s_add_u32 s47, s46, 4096
  v_lshrrev_b32 v5, 4, v1
  v_lshlrev_b32 v5, 10, v5
  v_and_b32 v12, 15, v1
  v_lshl_add_u32 v5, v12, 4, v5
  v_lshl_add_u32 v12, v12, 1, v7
  s_lshl_b32 s48, s36, 5
  v_add_lshl_u32 v12, v12, s48, 1
  v_mov_b32 v10, 0xc0135761
  v_mov_b32 v8, 0
  s_mov_b32 s62, 0x000f000f
  s_mov_b32 s63, 0x000f000f
  s_mov_b32 s59, 0
  s_waitcnt lgkmcnt(0)
  s_load_dword s40, s[28:29], s57
  s_load_dword s56, s[28:29], s58
  s_waitcnt lgkmcnt(0)
  s_barrier
  buffer_load_dwordx4 v[48:51], v2, s[16:19], s37 offen offset:0
  buffer_load_dwordx4 v[52:55], v2, s[16:19], s37 offen offset:2048
  s_add_u32 s37, s37, 4096
  buffer_load_dwordx4 v[56:59], v2, s[16:19], s37 offen offset:0
  buffer_load_dwordx4 v[60:63], v2, s[16:19], s37 offen offset:2048
  s_add_u32 s37, s37, 4096
  s_add_u32 s40, s40, 1
  s_add_u32 s56, s56, 1
  v_mov_b32 v25, s56
  v_mov_b32 v27, s56
  v_mov_b32 v9, s40
  s_waitcnt vmcnt(2)
  buffer_load_dwordx4 v[64:67], v2, s[16:19], s37 offen offset:0
  buffer_load_dwordx4 v[68:71], v2, s[16:19], s37 offen offset:2048
  s_add_u32 s37, s37, 4096
  v_perm_b32 v80, v52, v48, s41
  v_perm_b32 v81, v52, v48, s42
  v_perm_b32 v82, v53, v49, s41
  v_perm_b32 v83, v53, v49, s42
  v_perm_b32 v84, v54, v50, s41
  v_perm_b32 v85, v54, v50, s42
  v_perm_b32 v86, v55, v51, s41
  v_perm_b32 v87, v55, v51, s42
  s_waitcnt vmcnt(2)
  buffer_load_dwordx4 v[72:75], v2, s[16:19], s37 offen offset:0
  buffer_load_dwordx4 v[76:79], v2, s[16:19], s37 offen offset:2048
  v_perm_b32 v88, v60, v56, s41
  v_perm_b32 v89, v60, v56, s42
  v_perm_b32 v90, v61, v57, s41
  v_perm_b32 v91, v61, v57, s42
  v_perm_b32 v92, v62, v58, s41
  v_perm_b32 v93, v62, v58, s42
  v_perm_b32 v94, v63, v59, s41
  v_perm_b32 v95, v63, v59, s42
  s_waitcnt vmcnt(2)
  v_perm_b32 v96, v68, v64, s41
  v_perm_b32 v97, v68, v64, s42
  v_perm_b32 v98, v69, v65, s41
  v_perm_b32 v99, v69, v65, s42
  v_perm_b32 v100, v70, v66, s41
  v_perm_b32 v101, v70, v66, s42
  v_perm_b32 v102, v71, v67, s41
  v_perm_b32 v103, v71, v67, s42
  s_waitcnt vmcnt(0)
  s_barrier
  buffer_load_dwordx4 v[112:115], v5, s[28:31], s46 offen sc1
  buffer_load_dwordx4 v[116:119], v5, s[28:31], s47 offen sc1
  v_perm_b32 v104, v76, v72, s41
  v_perm_b32 v105, v76, v72, s42
  v_perm_b32 v106, v77, v73, s41
  v_perm_b32 v107, v77, v73, s42
  v_perm_b32 v108, v78, v74, s41
  v_perm_b32 v109, v78, v74, s42
  v_perm_b32 v110, v79, v75, s41
  v_perm_b32 v111, v79, v75, s42
  s_branch L_chk1
L_poll1:
  buffer_load_dwordx4 v[112:115], v5, s[28:31], s46 offen sc1
  buffer_load_dwordx4 v[116:119], v5, s[28:31], s47 offen sc1
L_chk1:
  s_add_u32 s59, s59, 1
  s_waitcnt vmcnt(1)
  v_xor_b32 v32, s40, v113
  v_xor_b32 v33, s40, v115
  s_waitcnt vmcnt(0)
  v_xor_b32 v34, s40, v117
  v_xor_b32 v35, s40, v119
  v_or3_b32 v15, v32, v33, v34
  v_or_b32 v15, v15, v35
  v_cmp_ne_u32 vcc, 0, v15
  s_and_b64 exec, vcc, vcc
  s_cbranch_scc0 L_got1
  s_cmp_lt_u32 s59, 0x400000
  s_cbranch_scc1 L_poll1
L_got1:
  s_mov_b64 exec, -1
  v_permlane32_swap_b32 v112, v114
  v_permlane32_swap_b32 v116, v118
  v_add_f32 v32, v112, v114
  v_add_f32 v34, v116, v118
  v_mov_b32 v33, v32
  v_mov_b32 v35, v34
  s_nop 0
  v_permlane16_swap_b32 v32, v33
  v_permlane16_swap_b32 v34, v35
  v_add_f32 v32, v32, v33
  v_add_f32 v34, v34, v35
  v_cvt_pk_bf16_f32 v32, v32, v34
  v_lshlrev_b32 v36, 16, v32
  v_and_b32 v34, 0xffff0000, v32
  v_mul_f32 v15, v36, v36
  v_fmac_f32 v10, 0xbdd2d3e8, v15
  v_mul_f32 v10, v10, v36
  v_exp_f32 v10, v10
  s_nop 0
  v_add_f32 v10, 1.0, v10
  v_rcp_f32 v10, v10
  s_nop 0
  v_mul_f32 v10, v10, v36
  v_cvt_pk_bf16_f32 v10, v10, v10
  v_lshlrev_b32 v10, 16, v10
  v_mul_f32 v10, v10, v34
  v_cvt_pk_bf16_f32 v10, v10, v10
  ds_write_b16 v12, v10
  s_waitcnt lgkmcnt(0)
  s_barrier
  ds_read_b128 v[40:43], v3
  s_waitcnt lgkmcnt(0)
  v_dot2c_f32_bf16 v16, v80, v40
  v_dot2c_f32_bf16 v17, v81, v40
  v_dot2c_f32_bf16 v18, v82, v40
  v_dot2c_f32_bf16 v19, v83, v40
  v_dot2c_f32_bf16 v20, v84, v40
  v_dot2c_f32_bf16 v21, v85, v40
  v_dot2c_f32_bf16 v22, v86, v40
  v_dot2c_f32_bf16 v23, v87, v40
  v_dot2c_f32_bf16 v16, v88, v41
  v_dot2c_f32_bf16 v17, v89, v41
  v_dot2c_f32_bf16 v18, v90, v41
  v_dot2c_f32_bf16 v19, v91, v41
  v_dot2c_f32_bf16 v20, v92, v41
  v_dot2c_f32_bf16 v21, v93, v41
  v_dot2c_f32_bf16 v22, v94, v41
  v_dot2c_f32_bf16 v23, v95, v41
  v_dot2c_f32_bf16 v16, v96, v42
  v_dot2c_f32_bf16 v17, v97, v42
  v_dot2c_f32_bf16 v18, v98, v42
  v_dot2c_f32_bf16 v19, v99, v42
  v_dot2c_f32_bf16 v20, v100, v42
  v_dot2c_f32_bf16 v21, v101, v42
  v_dot2c_f32_bf16 v22, v102, v42
  v_dot2c_f32_bf16 v23, v103, v42
  v_dot2c_f32_bf16 v16, v104, v43
  v_dot2c_f32_bf16 v17, v105, v43
  v_dot2c_f32_bf16 v18, v106, v43
  v_dot2c_f32_bf16 v19, v107, v43
  v_dot2c_f32_bf16 v20, v108, v43
  v_dot2c_f32_bf16 v21, v109, v43
  v_dot2c_f32_bf16 v22, v110, v43
  v_dot2c_f32_bf16 v23, v111, v43
  s_nop 0
  v_permlane32_swap_b32 v16, v20
  v_permlane32_swap_b32 v17, v21
  v_permlane32_swap_b32 v18, v22
  v_permlane32_swap_b32 v19, v23
  v_add_f32 v16, v16, v20
  v_add_f32 v17, v17, v21
  v_add_f32 v18, v18, v22
  v_add_f32 v19, v19, v23
  s_nop 0
  v_permlane16_swap_b32 v16, v18
  v_permlane16_swap_b32 v17, v19
  v_add_f32 v16, v16, v18
  v_add_f32 v17, v17, v19
  s_nop 0
  v_add_f32_dpp v16, v16, v16 row_ror:8 row_mask:0xf bank_mask:0xf
  v_add_f32_dpp v17, v17, v17 row_ror:8 row_mask:0xf bank_mask:0xf
  s_nop 0
  v_add_f32_dpp v24, v16, v16 row_ror:4 row_mask:0xf bank_mask:0xf
  v_add_f32_dpp v26, v17, v17 row_ror:4 row_mask:0xf bank_mask:0xf
  s_mov_b64 exec, s[62:63]
  buffer_store_dwordx4 v[24:27], v4, s[28:31], s52 offen
  buffer_store_dwordx4 v[24:27], v4, s[28:31], s53 offen sc1
  s_lshl_b32 s51, s34, 2
  s_add_u32 s51, s51, s36
  s_cmp_lg_u32 s51, 0
  s_cbranch_scc1 L_fin
  s_mov_b64 exec, 1
  buffer_store_dword v9, v8, s[28:31], s57 offen sc1
L_fin:
L_end:
  s_endpgm
.section .rodata,"a"
.p2align 6
.amdhsa_kernel standalone__glu_gated_geglu__decode_kernel
  .amdhsa_next_free_vgpr 120
  .amdhsa_next_free_sgpr 64
  .amdhsa_accum_offset 120
  .amdhsa_group_segment_fixed_size 0
  .amdhsa_kernarg_size 56
  .amdhsa_user_sgpr_count 2
  .amdhsa_user_sgpr_kernarg_segment_ptr 1
  .amdhsa_system_sgpr_workgroup_id_x 1
  .amdhsa_float_denorm_mode_32 3
.end_amdhsa_kernel
```
